```python
import torch

def _softmax(x, axis=-1):
    return torch.softmax(x, dim=axis)
def _gelu(x):
    return torch.nn.functional.gelu(x, approximate="tanh")
def _silu(x):
    return torch.nn.functional.silu(x)
def _sigmoid(x):
    return torch.sigmoid(x)
def _layernorm(x, axis=-1, eps=1e-5):
    m = x.mean(dim=axis, keepdim=True)
    v = x.var(dim=axis, keepdim=True, unbiased=False)
    return (x - m) / torch.sqrt(v + eps)
def _scatter_add(tgt, idx, src, axis=0):
    return tgt.clone().index_add_(axis, idx, src)
def _segment_sum(src, seg, n):
    out = torch.zeros((n,) + src.shape[1:], dtype=src.dtype)
    return out.index_add_(0, seg, src)
def _pad(x, pw):
    flat = tuple(v for pair in reversed(pw) for v in pair)
    return torch.nn.functional.pad(x, flat)

kernel_name = 'standalone__moe_arch_mod__prompt'

def setup_inputs():

    _w = (lambda a: (lambda t: t.to(torch.bfloat16) if t.is_floating_point() else t)(torch.as_tensor(a)))
    B, S, D, F, C = 1, 2048, 576, 4608, 1
    return {
        "x": _w((lambda *s: torch.randn(*s, dtype=torch.bfloat16) * 0.1)(B, S, D)),
        "w_r": _w((lambda *s: torch.randn(*s, dtype=torch.bfloat16) * 0.1)(D)),
        "w_gate": _w((lambda *s: torch.randn(*s, dtype=torch.bfloat16) * 0.1)(D, F)),
        "w_up": _w((lambda *s: torch.randn(*s, dtype=torch.bfloat16) * 0.1)(D, F)),
        "w_down": _w((lambda *s: torch.randn(*s, dtype=torch.bfloat16) * 0.1)(F, D)),
    }

def reference(x, w_r, w_gate, w_up, w_down):
    B, S, D = x.shape
    C = 1
    r = x @ w_r
    idx = torch.argsort(-r, axis=-1)[:, :C]
    idx_e = (lambda x, n, axis: torch.repeat_interleave(x, n, dim=axis))(idx.reshape(B, C, 1), D, axis=2)
    x_sel = (lambda x, i, axis: torch.take_along_dim(x, i, dim=axis))(x, idx_e, axis=1)
    g = _silu(x_sel @ w_gate)
    u = x_sel @ w_up
    y = (g * u) @ w_down
    r_sel = _sigmoid((lambda x, i, axis: torch.take_along_dim(x, i, dim=axis))(r, idx, axis=1))
    y = y * r_sel.reshape(B, C, 1)
    b_off = (torch.arange(B) * S).reshape(B, 1)
    flat_idx = (idx + b_off).reshape(B * C)
    zero = (x * 0.0).reshape(B * S, D)
    upd = _scatter_add(zero, flat_idx, y.reshape(B * C, D), axis=0)
    return x + upd.reshape(B, S, D)
```

```asm
; @launch grid=(256,1,1) block=(640,1,1) lds=8192
.amdgcn_target "amdgcn-amd-amdhsa--gfx950"
.text
.globl standalone__moe_arch_mod__prompt_kernel
.p2align 8
.type standalone__moe_arch_mod__prompt_kernel,@function
standalone__moe_arch_mod__prompt_kernel:
  s_load_dwordx16 s[4:19], s[0:1], 0
  v_lshrrev_b32 v1, 6, v0
  v_and_b32 v0, 63, v0
  v_readfirstlane_b32 s3, v1
  v_and_b32 v3, 7, v0
  v_lshrrev_b32 v2, 3, v0
  s_and_b32 s21, s2, 7
  s_cmp_eq_u32 s3, 9
  s_cbranch_scc0 L_notw9
  s_getpc_b64 s[44:45]
L_pc:
  v_min_u32 v28, (L_codeend-L_pc-4)/128, v0
  v_lshlrev_b32 v28, 7, v28
  global_load_dword v29, v28, s[44:45]
  s_branch L_w9
L_notw9:
  s_cmp_ge_u32 s2, 112
  s_cbranch_scc1 L_ffn
  s_lshl_b32 s22, s3, 7
  v_lshl_add_u32 v4, v3, 4, s22
  s_lshr_b32 s33, s2, 3
  s_mul_i32 s20, s33, 4668
  s_lshr_b32 s20, s20, 8
  s_lshl_b32 s23, s21, 8
  s_add_u32 s20, s20, s23
  s_mul_i32 s23, s20, 1152
  v_mul_u32_u24 v5, 3*1152, v2
  v_add3_u32 v5, v5, v4, s23
  s_waitcnt lgkmcnt(0)
  global_load_dwordx4 v[8:11], v4, s[6:7]
  s_mov_b32 exec_hi, 0x00ffffff
  global_load_dwordx4 v[16:19], v5, s[4:5]
  s_mov_b32 exec_hi, 0x0000ffff
  global_load_dwordx4 v[20:23], v5, s[4:5] offset:1152
  global_load_dwordx4 v[24:27], v5, s[4:5] offset:2304
  s_mov_b32 exec_hi, -1
  s_branch L_rt2
L_ffn:
  s_cmp_ge_u32 s2, 256
  s_cbranch_scc1 L_end
  s_sub_u32 s20, s2, 112
  s_lshr_b32 s20, s20, 3
  s_mul_i32 s22, s21, 18
  s_add_u32 s20, s20, s22
  s_cmp_ge_u32 s3, 4
  s_cbranch_scc1 L_dn
  s_movk_i32 s22, 9216
  s_mov_b32 s23, 0
  s_and_b32 s33, s20, 1
  s_lshl_b32 s33, s33, 5
  s_mul_i32 s34, s3, 144
  s_add_u32 s35, s34, s33
  s_mul_i32 s36, s35, s22
  s_lshl_b32 s37, s20, 6
  s_add_u32 s36, s36, s37
  v_mul_u32_u24 v4, 2*9216, v2
  v_and_b32 v5, 3, v0
  v_lshlrev_b32 v5, 4, v5
  v_add3_u32 v4, v4, v5, s36
  v_mov_b32 v5, 0
  s_mov_b32 exec_lo, 0x0f0f0f0f
  s_mov_b32 exec_hi, 0x0f0f0f0f
  s_waitcnt lgkmcnt(0)
  v_lshl_add_u64 v[4:5], v[4:5], 0, s[8:9]
  s_not_b64 exec, exec
  v_lshl_add_u64 v[4:5], v[4:5], 0, s[10:11]
  s_mov_b64 exec, -1
  global_load_dwordx4 v[100:103], v[4:5], off
  v_lshl_add_u64 v[4:5], v[4:5], 0, s[22:23]
  s_mov_b32 s30, 0x05040100
  s_mov_b32 s31, 0x07060302
  global_load_dwordx4 v[104:107], v[4:5], off
  s_mov_b32 s24, 0x21c00
  s_ashr_i32 s25, s24, 31
  v_lshl_add_u64 v[4:5], v[4:5], 0, s[24:25]
  global_load_dwordx4 v[108:111], v[4:5], off
  v_lshl_add_u64 v[4:5], v[4:5], 0, s[22:23]
  global_load_dwordx4 v[112:115], v[4:5], off
  s_mov_b32 s24, 0x69c00
  s_ashr_i32 s25, s24, 31
  v_lshl_add_u64 v[4:5], v[4:5], 0, s[24:25]
  s_waitcnt vmcnt(3)
  global_load_dwordx4 v[116:119], v[4:5], off
  v_lshl_add_u64 v[4:5], v[4:5], 0, s[22:23]
  s_waitcnt vmcnt(3)
  global_load_dwordx4 v[120:123], v[4:5], off
  s_mov_b32 s24, 0x21c00
  s_ashr_i32 s25, s24, 31
  v_lshl_add_u64 v[4:5], v[4:5], 0, s[24:25]
  v_perm_b32 v8, v104, v100, s30
  v_perm_b32 v16, v104, v100, s31
  v_perm_b32 v24, v105, v101, s30
  v_perm_b32 v32, v105, v101, s31
  v_perm_b32 v40, v106, v102, s30
  v_perm_b32 v48, v106, v102, s31
  v_perm_b32 v56, v107, v103, s30
  v_perm_b32 v64, v107, v103, s31
  v_and_b32 v6, 16, v0
  v_bfe_u32 v7, v0, 3, 1
  v_lshl_add_u32 v6, v7, 2, v6
  s_lshl_b32 s34, s34, 1
  v_add_u32 v6, s34, v6
  v_lshrrev_b32 v1, 5, v0
  v_lshlrev_b32 v1, 7, v1
  v_and_b32 v2, 1, v0
  v_mul_u32_u24 v92, 0xaaaa, v2
  v_add_u32 v92, 0x4444, v92
  v_lshl_add_u32 v2, v2, 6, v1
  s_lshl_b32 s33, s33, 1
  v_xor_b32 v2, s33, v2
  v_add_u32 v2, v2, v6
  v_add_u32 v6, 256, v6
  v_and_b32 v1, 3, v0
  v_bfe_u32 v72, v0, 2, 1
  v_lshl_add_u32 v1, v1, 1, v72
  v_mul_u32_u24 v1, 272, v1
  v_lshl_add_u32 v7, v7, 2, v1
  v_bfe_u32 v72, v0, 4, 1
  v_lshl_add_u32 v7, v72, 7, v7
  s_lshl_b32 s33, s3, 3
  s_add_u32 s33, s33, 2048
  v_add_u32 v7, s33, v7
  v_mov_b64 v[80:81], 0
  v_mov_b64 v[82:83], 0
  v_mov_b64 v[84:85], 0
  v_mov_b64 v[86:87], 0
  v_mov_b64 v[88:89], 0
  v_mov_b64 v[90:91], 0
  v_mov_b64 v[132:133], 0
  v_mov_b64 v[134:135], 0
  v_mov_b64 v[136:137], 0
  v_mov_b64 v[138:139], 0
  v_mov_b64 v[140:141], 0
  v_mov_b64 v[142:143], 0
  v_mov_b64 v[144:145], 0
  v_mov_b64 v[146:147], 0
  v_mov_b64 v[148:149], 0
  v_mov_b64 v[150:151], 0
  s_mov_b32 s38, 0x00ff00ff
  s_mov_b32 s39, 0xff00ff00
  s_mov_b32 s32, 0x0f0f0f0f
  s_mov_b32 s33, 0x0f0f0f0f
  s_mov_b32 s34, 0x03030303
  s_mov_b32 s35, 0x30303030
  s_mov_b32 s36, 0x0c0c0c0c
  s_mov_b32 s37, 0xc0c0c0c0
  s_sub_u32 s50, s2, 112
  s_lshr_b32 s50, s50, 3
  s_mul_i32 s51, s21, 6
  s_cmp_ge_u32 s50, 6
  s_cselect_b32 s51, 42, s51
  s_add_u32 s51, s51, s50
  s_cmp_eq_u32 s21, 7
  s_cselect_b32 s52, 12, 6
  s_cmp_lt_u32 s50, s52
  s_cselect_b32 s51, s51, 63
  s_mul_i32 s52, s51, 9
  s_add_u32 s52, s52, s3
  s_lshl_b32 s52, s52, 10
  v_lshl_add_u32 v152, v0, 4, s52
  v_and_b32 v153, 3, v0
  v_lshrrev_b32 v154, 4, v0
  v_lshl_add_u32 v153, v153, 2, v154
  v_mul_u32_u24 v153, 48, v153
  s_lshl_b32 s52, s3, 2
  s_add_u32 s52, s52, 5120
  v_add_u32 v153, s52, v153
  v_mov_b32 v154, 4352
  s_waitcnt vmcnt(3)
  global_load_dwordx4 v[124:127], v[4:5], off
  v_lshl_add_u64 v[4:5], v[4:5], 0, s[22:23]
  s_waitcnt vmcnt(3)
  global_load_dwordx4 v[100:103], v[4:5], off
  s_mov_b32 s24, 0xfff91c00
  s_bitcmp1_b32 s20, 0
  s_cselect_b32 s24, 0xfff01c00, s24
  s_ashr_i32 s25, s24, 31
  v_lshl_add_u64 v[4:5], v[4:5], 0, s[24:25]
  s_barrier
  global_load_dwordx4 v[104:107], v[4:5], off
  v_lshl_add_u64 v[4:5], v[4:5], 0, s[22:23]
  v_perm_b32 v10, v112, v108, s30
  v_perm_b32 v18, v112, v108, s31
  v_perm_b32 v26, v113, v109, s30
  v_perm_b32 v34, v113, v109, s31
  v_perm_b32 v42, v114, v110, s30
  v_perm_b32 v50, v114, v110, s31
  v_perm_b32 v58, v115, v111, s30
  v_perm_b32 v66, v115, v111, s31
  s_waitcnt vmcnt(4)
  global_load_dwordx4 v[108:111], v[4:5], off
  s_mov_b32 s24, 0x21c00
  s_ashr_i32 s25, s24, 31
  v_lshl_add_u64 v[4:5], v[4:5], 0, s[24:25]
  s_waitcnt vmcnt(4)
  global_load_dwordx4 v[112:115], v[4:5], off
  v_lshl_add_u64 v[4:5], v[4:5], 0, s[22:23]
  v_perm_b32 v12, v120, v116, s30
  v_perm_b32 v20, v120, v116, s31
  v_perm_b32 v28, v121, v117, s30
  v_perm_b32 v36, v121, v117, s31
  v_perm_b32 v44, v122, v118, s30
  v_perm_b32 v52, v122, v118, s31
  v_perm_b32 v60, v123, v119, s30
  v_perm_b32 v68, v123, v119, s31
  s_waitcnt vmcnt(4)
  global_load_dwordx4 v[116:119], v[4:5], off
  s_mov_b32 s24, 0x69c00
  s_ashr_i32 s25, s24, 31
  v_lshl_add_u64 v[4:5], v[4:5], 0, s[24:25]
  s_barrier
  s_waitcnt vmcnt(4)
  global_load_dwordx4 v[120:123], v[4:5], off
  v_lshl_add_u64 v[4:5], v[4:5], 0, s[22:23]
  v_perm_b32 v14, v100, v124, s30
  v_perm_b32 v22, v100, v124, s31
  v_perm_b32 v30, v101, v125, s30
  v_perm_b32 v38, v101, v125, s31
  v_perm_b32 v46, v102, v126, s30
  v_perm_b32 v54, v102, v126, s31
  v_perm_b32 v62, v103, v127, s30
  v_perm_b32 v70, v103, v127, s31
  s_waitcnt vmcnt(4)
  global_load_dwordx4 v[124:127], v[4:5], off
  s_mov_b32 s24, 0x21c00
  s_ashr_i32 s25, s24, 31
  v_lshl_add_u64 v[4:5], v[4:5], 0, s[24:25]
  s_waitcnt vmcnt(4)
  global_load_dwordx4 v[100:103], v[4:5], off
  v_lshl_add_u64 v[4:5], v[4:5], 0, s[22:23]
  v_perm_b32 v9, v108, v104, s30
  v_perm_b32 v17, v108, v104, s31
  v_perm_b32 v25, v109, v105, s30
  v_perm_b32 v33, v109, v105, s31
  v_perm_b32 v41, v110, v106, s30
  v_perm_b32 v49, v110, v106, s31
  v_perm_b32 v57, v111, v107, s30
  v_perm_b32 v65, v111, v107, s31
  s_waitcnt vmcnt(4)
  global_load_dwordx4 v[104:107], v[4:5], off
  s_mov_b32 s24, 0x21c00
  s_bitcmp1_b32 s20, 0
  s_cselect_b32 s24, 0x69c00, s24
  s_ashr_i32 s25, s24, 31
  v_lshl_add_u64 v[4:5], v[4:5], 0, s[24:25]
  s_waitcnt vmcnt(4)
  global_load_dwordx4 v[108:111], v[4:5], off
  v_lshl_add_u64 v[4:5], v[4:5], 0, s[22:23]
  v_perm_b32 v11, v116, v112, s30
  v_perm_b32 v19, v116, v112, s31
  v_perm_b32 v27, v117, v113, s30
  v_perm_b32 v35, v117, v113, s31
  v_perm_b32 v43, v118, v114, s30
  v_perm_b32 v51, v118, v114, s31
  v_perm_b32 v59, v119, v115, s30
  v_perm_b32 v67, v119, v115, s31
  s_waitcnt vmcnt(4)
  global_load_dwordx4 v[112:115], v[4:5], off
  s_barrier
  s_waitcnt vmcnt(4)
  v_perm_b32 v13, v124, v120, s30
  v_perm_b32 v21, v124, v120, s31
  v_perm_b32 v29, v125, v121, s30
  v_perm_b32 v37, v125, v121, s31
  v_perm_b32 v45, v126, v122, s30
  v_perm_b32 v53, v126, v122, s31
  v_perm_b32 v61, v127, v123, s30
  v_perm_b32 v69, v127, v123, s31
  s_waitcnt vmcnt(2)
  v_perm_b32 v15, v104, v100, s30
  v_perm_b32 v23, v104, v100, s31
  v_perm_b32 v31, v105, v101, s30
  v_perm_b32 v39, v105, v101, s31
  v_perm_b32 v47, v106, v102, s30
  v_perm_b32 v55, v106, v102, s31
  v_perm_b32 v63, v107, v103, s30
  v_perm_b32 v71, v107, v103, s31
  s_mov_b64 exec, s[32:33]
  s_barrier
  ds_read2_b32 v[80:81], v2 offset0:0 offset1:8
  ds_read2_b32 v[82:83], v2 offset0:2 offset1:10
  s_not_b64 exec, s[32:33]
  ds_read2_b32 v[84:85], v2 offset0:0 offset1:8
  ds_read2_b32 v[86:87], v2 offset0:2 offset1:10
  s_mov_b64 exec, s[34:35]
  ds_read_b32 v88, v6
  ds_read_b32 v90, v6 offset:8
  s_mov_b64 exec, s[36:37]
  ds_read_b32 v89, v6
  ds_read_b32 v91, v6 offset:8
  s_mov_b64 exec, -1
  s_waitcnt lgkmcnt(6)
  v_smfmac_f32_16x16x64_bf16 v[132:135], v[80:83], v[8:15], v92
  v_smfmac_f32_16x16x64_bf16 v[136:139], v[80:83], v[16:23], v92
  v_smfmac_f32_16x16x64_bf16 v[140:143], v[80:83], v[24:31], v92
  v_smfmac_f32_16x16x64_bf16 v[144:147], v[80:83], v[32:39], v92
  s_waitcnt vmcnt(0) lgkmcnt(4)
  v_perm_b32 v72, v112, v108, s30
  v_perm_b32 v73, v112, v108, s31
  v_smfmac_f32_16x16x64_bf16 v[132:135], v[84:87], v[40:47], v92
  v_perm_b32 v74, v113, v109, s30
  v_perm_b32 v75, v113, v109, s31
  v_smfmac_f32_16x16x64_bf16 v[136:139], v[84:87], v[48:55], v92
  v_perm_b32 v76, v114, v110, s30
  v_perm_b32 v77, v114, v110, s31
  v_smfmac_f32_16x16x64_bf16 v[140:143], v[84:87], v[56:63], v92
  v_perm_b32 v78, v115, v111, s30
  v_perm_b32 v79, v115, v111, s31
  v_smfmac_f32_16x16x64_bf16 v[144:147], v[84:87], v[64:71], v92
  s_waitcnt lgkmcnt(0)
  v_smfmac_f32_16x16x64_bf16 v[148:151], v[88:91], v[72:79], v92
  s_mov_b64 exec, s[38:39]
  v_add_f32 v96, v132, v133
  v_add_f32 v97, v136, v137
  v_add_f32 v98, v140, v141
  s_nop 1
  v_add_f32 v99, v144, v145
  s_cmp_lg_u32 s51, 63
  v_pk_add_f32 v[96:97], v[96:97], v[148:149]
  v_pk_add_f32 v[98:99], v[98:99], v[150:151]
  ds_write2_b32 v7, v96, v97 offset0:0 offset1:8
  ds_write2_b32 v7, v98, v99 offset0:16 offset1:24
  s_waitcnt lgkmcnt(0)
  s_barrier
  s_cbranch_scc1 L_red
  s_endpgm
L_dn:
  s_sub_u32 s50, s2, 112
  s_lshr_b32 s50, s50, 3
  s_mul_i32 s51, s21, 6
  s_cmp_ge_u32 s50, 6
  s_cselect_b32 s51, 42, s51
  s_add_u32 s51, s51, s50
  s_cmp_eq_u32 s21, 7
  s_cselect_b32 s52, 12, 6
  s_cmp_lt_u32 s50, s52
  s_cselect_b32 s51, s51, 63
  s_mul_i32 s52, s51, 9
  s_add_u32 s52, s52, s3
  s_lshl_b32 s52, s52, 10
  v_lshl_add_u32 v152, v0, 4, s52
  v_and_b32 v153, 3, v0
  v_lshrrev_b32 v154, 4, v0
  v_lshl_add_u32 v153, v153, 2, v154
  v_mul_u32_u24 v153, 48, v153
  s_lshl_b32 s52, s3, 2
  s_add_u32 s52, s52, 5120
  v_add_u32 v153, s52, v153
  v_mov_b32 v154, 4352
  s_cmp_eq_u32 s3, 8
  s_cbranch_scc1 L_w8
  s_sub_u32 s33, s3, 4
  s_mul_i32 s24, s20, 32*1152
  s_lshl_b32 s25, s33, 8
  s_add_u32 s24, s24, s25
  v_lshrrev_b32 v1, 5, v0
  v_bfe_u32 v2, v0, 4, 1
  v_lshl_add_u32 v1, v1, 3, v2
  v_mul_u32_u24 v4, 1152, v1
  v_and_b32 v2, 15, v0
  v_lshl_add_u32 v4, v2, 4, v4
  s_add_u32 s24, s24, 3456
  v_add_u32 v4, s24, v4
  v_add_u32 v5, 16*1152, v4
  s_mov_b32 s32, 0xbfb8aa3b
  v_bfe_u32 v6, v0, 2, 2
  v_sub_u32 v1, v2, v6
  v_and_b32 v6, 1, v1
  v_lshlrev_b32 v6, 4, v6
  v_mov_b32 v7, 0xffff
  v_lshlrev_b32 v6, v6, v7
  v_bfe_u32 v102, v1, 1, 1
  v_mul_u32_u24 v102, 0xaaaa, v102
  v_add_u32 v102, 0x4444, v102
  s_mov_b32 s36, 0x00170017
  s_mov_b32 s37, 0x00170017
  s_mov_b32 s38, 0x03600360
  s_mov_b32 s39, 0x03600360
  v_cndmask_b32 v100, 0, v6, s[36:37]
  v_cndmask_b32 v101, 0, v6, s[38:39]
  v_lshrrev_b32 v7, 3, v0
  v_lshl_add_u32 v7, v0, 1, v7
  v_lshlrev_b32 v7, 4, v7
  v_add_u32 v7, 2048, v7
  v_bfe_u32 v103, v0, 3, 1
  v_mul_u32_u24 v103, 3, v103
  v_lshrrev_b32 v6, 4, v0
  v_add_u32 v103, v103, v6
  v_bfe_u32 v6, v0, 2, 1
  v_lshl_add_u32 v103, v103, 1, v6
  v_mul_u32_u24 v103, 9216, v103
  v_and_b32 v6, 3, v0
  v_lshl_add_u32 v103, v6, 4, v103
  s_lshl_b32 s26, s20, 6
  s_mul_i32 s25, s33, 110592
  s_add_u32 s25, s25, s26
  v_add_u32 v103, s25, v103
  v_add_u32 v104, 110592, v103
  v_mov_b64 v[88:89], 0
  v_mov_b64 v[90:91], 0
  v_mov_b64 v[92:93], 0
  v_mov_b64 v[94:95], 0
  s_mov_b32 s34, 0x00ff00ff
  s_mov_b32 s35, 0x00ff00ff
  s_mov_b32 s40, -1
  s_mov_b32 s41, 0xffff
  s_waitcnt lgkmcnt(0)
  s_barrier
  s_barrier
  s_cmp_eq_u32 s3, 7
  s_cbranch_scc1 L_dnt
  s_barrier
  global_load_dwordx4 v[8:11], v4, s[12:13] offset:-3456
  global_load_dwordx4 v[12:15], v5, s[12:13] offset:-3456
  global_load_dwordx4 v[16:19], v4, s[12:13] offset:-1152
  global_load_dwordx4 v[20:23], v5, s[12:13] offset:-1152
  global_load_dwordx4 v[24:27], v4, s[12:13] offset:1152
  global_load_dwordx4 v[28:31], v5, s[12:13] offset:1152
  s_barrier
  global_load_dwordx4 v[32:35], v4, s[12:13] offset:3456
  global_load_dwordx4 v[36:39], v5, s[12:13] offset:3456
  ds_read_b32 v105, v154
  s_cmp_lg_u32 s51, 63
  s_barrier
  ds_read_b128 v[108:111], v7
  ds_read_b128 v[112:115], v7 offset:16
  s_waitcnt lgkmcnt(1)
  v_pk_add_f32 v[108:109], v[108:109], v[110:111]
  s_waitcnt lgkmcnt(0)
  v_pk_add_f32 v[112:113], v[112:113], v[114:115]
  v_pk_add_f32 v[108:109], v[108:109], v[112:113]
  v_add_f32 v108, v108, v109
  v_cvt_pk_bf16_f32 v108, 0, v108
  v_mul_f32 v109, s32, v108
  v_exp_f32 v109, v109
  v_mov_b32_dpp v111, v108 row_ror:8 row_mask:0xf bank_mask:0xf
  v_add_f32 v109, 1.0, v109
  v_rcp_f32 v109, v109
  s_nop 0
  v_mul_f32 v109, v108, v109
  v_cvt_pk_bf16_f32 v109, 0, v109
  v_mul_f32 v110, v111, v109
  v_cvt_pk_bf16_f32 v110, v110, v110
  s_nop 1
  v_and_b32_dpp v72, v110, v100 row_newbcast:0 row_mask:0xf bank_mask:0xf
  v_and_b32_dpp v73, v110, v101 row_newbcast:0 row_mask:0xf bank_mask:0xf
  v_and_b32_dpp v74, v110, v100 row_newbcast:1 row_mask:0xf bank_mask:0xf
  v_and_b32_dpp v75, v110, v101 row_newbcast:1 row_mask:0xf bank_mask:0xf
  v_and_b32_dpp v76, v110, v100 row_newbcast:2 row_mask:0xf bank_mask:0xf
  s_waitcnt vmcnt(6)
  v_smfmac_f32_16x16x64_bf16 v[88:91], v[72:75], v[8:15], v102
  v_and_b32_dpp v77, v110, v101 row_newbcast:2 row_mask:0xf bank_mask:0xf
  v_and_b32_dpp v78, v110, v100 row_newbcast:3 row_mask:0xf bank_mask:0xf
  v_and_b32_dpp v79, v110, v101 row_newbcast:3 row_mask:0xf bank_mask:0xf
  v_and_b32_dpp v80, v110, v100 row_newbcast:4 row_mask:0xf bank_mask:0xf
  s_waitcnt vmcnt(4)
  v_smfmac_f32_16x16x64_bf16 v[88:91], v[76:79], v[16:23], v102
  v_and_b32_dpp v81, v110, v101 row_newbcast:4 row_mask:0xf bank_mask:0xf
  v_and_b32_dpp v82, v110, v100 row_newbcast:5 row_mask:0xf bank_mask:0xf
  v_and_b32_dpp v83, v110, v101 row_newbcast:5 row_mask:0xf bank_mask:0xf
  v_and_b32_dpp v84, v110, v100 row_newbcast:6 row_mask:0xf bank_mask:0xf
  s_waitcnt vmcnt(2)
  v_smfmac_f32_16x16x64_bf16 v[88:91], v[80:83], v[24:31], v102
  v_and_b32_dpp v85, v110, v101 row_newbcast:6 row_mask:0xf bank_mask:0xf
  v_and_b32_dpp v86, v110, v100 row_newbcast:7 row_mask:0xf bank_mask:0xf
  v_and_b32_dpp v87, v110, v101 row_newbcast:7 row_mask:0xf bank_mask:0xf
  s_nop 0
  s_waitcnt vmcnt(0)
  v_smfmac_f32_16x16x64_bf16 v[88:91], v[84:87], v[32:39], v102
  s_mov_b64 exec, s[40:41]
  s_nop 6
  v_mov_b32 v91, v105
  global_store_dwordx4 v103, v[88:91], s[18:19] sc1
  s_cbranch_scc1 L_red
  s_endpgm
L_dnt:
  s_barrier
  s_mov_b64 exec, s[34:35]
  global_load_dwordx4 v[40:43], v4, s[12:13] offset:-3200
  global_load_dwordx4 v[44:47], v5, s[12:13] offset:-3200
  s_mov_b64 exec, -1
  global_load_dwordx4 v[8:11], v4, s[12:13] offset:-3456
  global_load_dwordx4 v[12:15], v5, s[12:13] offset:-3456
  s_mov_b64 exec, s[34:35]
  global_load_dwordx4 v[48:51], v4, s[12:13] offset:-896
  global_load_dwordx4 v[52:55], v5, s[12:13] offset:-896
  s_barrier
  s_mov_b64 exec, -1
  global_load_dwordx4 v[16:19], v4, s[12:13] offset:-1152
  global_load_dwordx4 v[20:23], v5, s[12:13] offset:-1152
  s_mov_b64 exec, s[34:35]
  global_load_dwordx4 v[56:59], v4, s[12:13] offset:1408
  global_load_dwordx4 v[60:63], v5, s[12:13] offset:1408
  s_mov_b64 exec, -1
  global_load_dwordx4 v[24:27], v4, s[12:13] offset:1152
  global_load_dwordx4 v[28:31], v5, s[12:13] offset:1152
  s_mov_b64 exec, s[34:35]
  global_load_dwordx4 v[64:67], v4, s[12:13] offset:3712
  global_load_dwordx4 v[68:71], v5, s[12:13] offset:3712
  s_mov_b64 exec, -1
  global_load_dwordx4 v[32:35], v4, s[12:13] offset:3456
  global_load_dwordx4 v[36:39], v5, s[12:13] offset:3456
  ds_read_b32 v105, v154
  s_cmp_lg_u32 s51, 63
  s_barrier
  ds_read_b128 v[108:111], v7
  ds_read_b128 v[112:115], v7 offset:16
  s_waitcnt lgkmcnt(1)
  v_pk_add_f32 v[108:109], v[108:109], v[110:111]
  s_waitcnt lgkmcnt(0)
  v_pk_add_f32 v[112:113], v[112:113], v[114:115]
  v_pk_add_f32 v[108:109], v[108:109], v[112:113]
  v_add_f32 v108, v108, v109
  v_cvt_pk_bf16_f32 v108, 0, v108
  v_mul_f32 v109, s32, v108
  v_exp_f32 v109, v109
  v_mov_b32_dpp v111, v108 row_ror:8 row_mask:0xf bank_mask:0xf
  v_add_f32 v109, 1.0, v109
  v_rcp_f32 v109, v109
  s_nop 0
  v_mul_f32 v109, v108, v109
  v_cvt_pk_bf16_f32 v109, 0, v109
  v_mul_f32 v110, v111, v109
  v_cvt_pk_bf16_f32 v110, v110, v110
  s_nop 1
  v_and_b32_dpp v72, v110, v100 row_newbcast:0 row_mask:0xf bank_mask:0xf
  v_and_b32_dpp v73, v110, v101 row_newbcast:0 row_mask:0xf bank_mask:0xf
  v_and_b32_dpp v74, v110, v100 row_newbcast:1 row_mask:0xf bank_mask:0xf
  v_and_b32_dpp v75, v110, v101 row_newbcast:1 row_mask:0xf bank_mask:0xf
  v_and_b32_dpp v76, v110, v100 row_newbcast:2 row_mask:0xf bank_mask:0xf
  s_waitcnt vmcnt(14)
  v_smfmac_f32_16x16x64_bf16 v[92:95], v[72:75], v[40:47], v102
  v_and_b32_dpp v77, v110, v101 row_newbcast:2 row_mask:0xf bank_mask:0xf
  v_and_b32_dpp v78, v110, v100 row_newbcast:3 row_mask:0xf bank_mask:0xf
  s_waitcnt vmcnt(12)
  v_smfmac_f32_16x16x64_bf16 v[88:91], v[72:75], v[8:15], v102
  v_and_b32_dpp v79, v110, v101 row_newbcast:3 row_mask:0xf bank_mask:0xf
  v_and_b32_dpp v80, v110, v100 row_newbcast:4 row_mask:0xf bank_mask:0xf
  s_waitcnt vmcnt(10)
  v_smfmac_f32_16x16x64_bf16 v[92:95], v[76:79], v[48:55], v102
  v_and_b32_dpp v81, v110, v101 row_newbcast:4 row_mask:0xf bank_mask:0xf
  v_and_b32_dpp v82, v110, v100 row_newbcast:5 row_mask:0xf bank_mask:0xf
  s_waitcnt vmcnt(8)
  v_smfmac_f32_16x16x64_bf16 v[88:91], v[76:79], v[16:23], v102
  v_and_b32_dpp v83, v110, v101 row_newbcast:5 row_mask:0xf bank_mask:0xf
  v_and_b32_dpp v84, v110, v100 row_newbcast:6 row_mask:0xf bank_mask:0xf
  s_waitcnt vmcnt(6)
  v_smfmac_f32_16x16x64_bf16 v[92:95], v[80:83], v[56:63], v102
  v_and_b32_dpp v85, v110, v101 row_newbcast:6 row_mask:0xf bank_mask:0xf
  v_and_b32_dpp v86, v110, v100 row_newbcast:7 row_mask:0xf bank_mask:0xf
  s_waitcnt vmcnt(4)
  v_smfmac_f32_16x16x64_bf16 v[88:91], v[80:83], v[24:31], v102
  v_and_b32_dpp v87, v110, v101 row_newbcast:7 row_mask:0xf bank_mask:0xf
  s_nop 0
  s_waitcnt vmcnt(2)
  v_smfmac_f32_16x16x64_bf16 v[92:95], v[84:87], v[64:71], v102
  s_waitcnt vmcnt(0)
  v_smfmac_f32_16x16x64_bf16 v[88:91], v[84:87], v[32:39], v102
  s_mov_b32 exec_lo, s34
  s_movk_i32 exec_hi, 0xff
  s_nop 3
  v_mov_b32 v95, v105
  global_store_dwordx4 v104, v[92:95], s[18:19] sc1
  s_mov_b64 exec, s[40:41]
  v_mov_b32 v91, v105
  global_store_dwordx4 v103, v[88:91], s[18:19] sc1
  s_cbranch_scc1 L_red
  s_endpgm
L_w8:
  s_cmp_lg_u32 s51, 63
  s_cbranch_scc0 L_end
  s_waitcnt lgkmcnt(0)
  s_barrier
  s_barrier
  s_barrier
  s_barrier
  s_barrier
L_red:
  s_mov_b64 exec, -1
  ds_read_b32 v9, v154
  s_mov_b32 s34, 0x000f000f
  s_mov_b32 s35, 0x000f000f
  s_mov_b32 s57, 262144
  s_waitcnt vmcnt(0) lgkmcnt(0)
  s_barrier
L_red_loop:
  s_mov_b64 exec, -1
  global_load_dwordx4 v[12:15], v152, s[18:19] sc1
  s_sub_u32 s57, s57, 1
  s_cselect_b64 s[36:37], -1, 0
  s_waitcnt vmcnt(0)
  v_permlane32_swap_b32 v12, v14
  v_permlane32_swap_b32 v13, v18
  v_add_f32 v16, v12, v14
  v_add_f32 v17, v13, v18
  v_cmp_eq_u32 vcc, v15, v9
  s_nop 0
  v_permlane16_swap_b32 v16, v17
  v_add_f32 v16, v16, v17
  s_or_b64 vcc, vcc, s[36:37]
  s_cmp_eq_u64 vcc, -1
  v_add_f32_dpp v16, v16, v16 row_ror:4 row_mask:0xf bank_mask:0xf
  s_nop 1
  v_add_f32_dpp v16, v16, v16 row_ror:8 row_mask:0xf bank_mask:0xf
  s_mov_b64 exec, s[34:35]
  ds_write_b32 v153, v16
  s_cbranch_scc0 L_red_loop
  s_waitcnt lgkmcnt(0)
  s_barrier
  s_lshl4_add_u32 s52, s51, s3
  s_cmp_lg_u32 s52, 328
  s_cbranch_scc1 L_noep
  s_mov_b64 exec, 1
  v_mov_b32 v10, 0xa0000
  global_store_dword v10, v9, s[18:19]
L_noep:
  s_endpgm
L_rt2:
  s_lshl_b32 s25, s3, 2
  v_mul_u32_u24 v41, 3*48, v2
  v_add_u32 v41, s25, v41
  s_mov_b32 s28, 0x01010101
  s_mov_b32 s29, 0x01010101
  s_mul_i32 s27, s3, 14
  s_add_u32 s27, s27, s33
  s_mul_i32 s26, s21, 663552
  s_mul_i32 s34, s27, 42
  v_add_u32 v42, s34, v0
  v_min_u32 v42, 5183, v42
  v_mul_u32_u24 v49, 58255, v42
  v_lshrrev_b32 v49, 21, v49
  v_cmp_gt_u32 vcc, 2592, v42
  v_mad_u32_u24 v42, v49, 36, v42
  v_mov_b32 v49, -5184
  v_cndmask_b32 v49, v49, 36, vcc
  v_add_u32 v42, v42, v49
  v_lshl_add_u32 v42, v42, 7, s26
  s_mul_i32 s38, s27, 5
  v_add_u32 v49, s38, v0
  v_min_u32 v49, 575, v49
  v_mul_u32_u24 v50, 7282, v49
  v_lshrrev_b32 v50, 16, v50
  v_mul_u32_u24 v51, 9, v50
  v_sub_u32 v51, v49, v51
  v_lshrrev_b32 v52, 4, v50
  v_lshl_add_u32 v50, v52, 7, v50
  v_add_u32 v50, 128, v50
  v_mul_u32_u24 v50, 9216, v50
  v_lshl_add_u32 v50, v51, 7, v50
  s_mul_i32 s39, s21, 1152
  v_add_u32 v50, s39, v50
  v_lshl_add_u32 v55, s27, 2, v0
  v_min_u32 v55, 485, v55
  v_mul_u32_u24 v56, 7282, v55
  v_lshrrev_b32 v56, 16, v56
  v_mul_u32_u24 v56, 63, v56
  v_add_u32 v55, v55, v56
  v_lshl_add_u32 v55, v55, 7, s39
  s_mul_i32 s38, s27, 3
  v_add_u32 v49, s38, v3
  v_min_u32 v49, 255, v49
  v_lshrrev_b32 v51, 6, v49
  v_lshlrev_b32 v51, 2, v51
  s_movk_i32 s38, 0x7564
  v_bfe_u32 v51, s38, v51, 4
  v_bfe_u32 v52, v49, 4, 2
  v_mul_u32_u24 v52, 144, v52
  v_lshl_add_u32 v51, v51, 4, v52
  v_and_b32 v49, 15, v49
  v_add_u32 v51, v51, v49
  v_mul_u32_u24 v51, 9216, v51
  s_sub_u32 s38, 3, s21
  s_and_b32 s38, s38, 7
  s_lshl_b32 s41, s38, 7
  s_add_u32 s41, s41, s39
  v_add_u32 v51, s41, v51
  s_cmp_eq_u32 s38, 0
  s_cselect_b32 s41, 1024, 0
  s_cselect_b32 s37, 0x707, 7
  v_add_u32 v52, s41, v51
  v_cmp_eq_u32 vcc, 4, v2
  s_nop 1
  v_cndmask_b32 v50, v50, v51, vcc
  v_cmp_eq_u32 vcc, 5, v2
  s_mov_b32 s36, 0x1f
  s_nop 0
  v_cndmask_b32 v50, v50, v52, vcc
  s_mov_b64 exec, s[36:37]
  s_waitcnt vmcnt(0)
  global_load_dword v49, v50, s[8:9]
  global_load_dword v51, v50, s[10:11]
  s_mov_b64 exec, -1
  v_dot2_f32_bf16 v32, v16, v8, 0
  v_dot2_f32_bf16 v33, v20, v8, 0
  v_dot2_f32_bf16 v34, v24, v8, 0
  v_dot2_f32_bf16 v32, v17, v9, v32
  v_dot2_f32_bf16 v33, v21, v9, v33
  v_dot2_f32_bf16 v34, v25, v9, v34
  v_dot2_f32_bf16 v32, v18, v10, v32
  v_dot2_f32_bf16 v33, v22, v10, v33
  v_dot2_f32_bf16 v34, v26, v10, v34
  v_dot2_f32_bf16 v32, v19, v11, v32
  v_dot2_f32_bf16 v33, v23, v11, v33
  v_dot2_f32_bf16 v34, v27, v11, v34
  s_nop 0
  v_add_f32_dpp v32, v32, v32 quad_perm:[1,0,3,2] row_mask:0xf bank_mask:0xf
  v_add_f32_dpp v33, v33, v33 quad_perm:[1,0,3,2] row_mask:0xf bank_mask:0xf
  v_add_f32_dpp v34, v34, v34 quad_perm:[1,0,3,2] row_mask:0xf bank_mask:0xf
  v_add_f32_dpp v32, v32, v32 quad_perm:[2,3,0,1] row_mask:0xf bank_mask:0xf
  v_add_f32_dpp v33, v33, v33 quad_perm:[2,3,0,1] row_mask:0xf bank_mask:0xf
  v_add_f32_dpp v34, v34, v34 quad_perm:[2,3,0,1] row_mask:0xf bank_mask:0xf
  v_add_f32_dpp v32, v32, v32 row_half_mirror row_mask:0xf bank_mask:0xf
  v_add_f32_dpp v33, v33, v33 row_half_mirror row_mask:0xf bank_mask:0xf
  v_add_f32_dpp v34, v34, v34 row_half_mirror row_mask:0xf bank_mask:0xf
  s_mov_b64 exec, s[28:29]
  ds_write2_b32 v41, v32, v33 offset0:0 offset1:12
  ds_write_b32 v41, v34 offset:96
  s_mov_b64 exec, 15
  s_waitcnt lgkmcnt(0)
  s_barrier
  s_barrier
  s_waitcnt vmcnt(0)
  global_load_dword v57, v55, s[18:19] sc1
  s_mov_b32 exec_lo, -1
  s_movk_i32 exec_hi, 0x3ff
  global_load_dword v48, v42, s[12:13]
  s_mov_b64 exec, -1
  s_add_u32 s24, s33, 1
  s_mul_i32 s24, s24, 4668
  s_lshr_b32 s24, s24, 8
  s_and_b32 s25, s20, 255
  s_sub_u32 s24, s24, s25
  s_cmp_eq_u32 s33, 13
  s_cselect_b32 s24, 19, s24
  s_mov_b32 s25, 0x0000ffff
  s_cmp_eq_u32 s24, 19
  s_cselect_b32 s24, 0x00ffffff, s25
  v_mul_u32_u24 v34, 3, v2
  v_mov_b32 v35, 4352
  s_mov_b32 s30, 0xffff0000
  s_mov_b32 s31, 0x07060302
  s_waitcnt vmcnt(0)
  s_barrier
  s_barrier
  ds_read_b32 v35, v35
  v_lshlrev_b32 v32, 16, v16
  v_and_b32 v33, s30, v16
  v_fma_f32 v32, v32, 0, v32
  v_fma_f32 v33, v33, 0, v33
  v_perm_b32 v16, v33, v32, s31
  v_lshlrev_b32 v32, 16, v17
  v_and_b32 v33, s30, v17
  v_fma_f32 v32, v32, 0, v32
  v_fma_f32 v33, v33, 0, v33
  v_perm_b32 v17, v33, v32, s31
  v_lshlrev_b32 v32, 16, v18
  v_and_b32 v33, s30, v18
  v_fma_f32 v32, v32, 0, v32
  v_fma_f32 v33, v33, 0, v33
  v_perm_b32 v18, v33, v32, s31
  v_lshlrev_b32 v32, 16, v19
  v_and_b32 v33, s30, v19
  v_fma_f32 v32, v32, 0, v32
  v_fma_f32 v33, v33, 0, v33
  v_perm_b32 v19, v33, v32, s31
  v_lshlrev_b32 v32, 16, v20
  v_and_b32 v33, s30, v20
  v_fma_f32 v32, v32, 0, v32
  v_fma_f32 v33, v33, 0, v33
  v_perm_b32 v20, v33, v32, s31
  v_lshlrev_b32 v32, 16, v21
  v_and_b32 v33, s30, v21
  v_fma_f32 v32, v32, 0, v32
  v_fma_f32 v33, v33, 0, v33
  v_perm_b32 v21, v33, v32, s31
  v_lshlrev_b32 v32, 16, v22
  v_and_b32 v33, s30, v22
  v_fma_f32 v32, v32, 0, v32
  v_fma_f32 v33, v33, 0, v33
  v_perm_b32 v22, v33, v32, s31
  v_lshlrev_b32 v32, 16, v23
  v_and_b32 v33, s30, v23
  v_fma_f32 v32, v32, 0, v32
  v_fma_f32 v33, v33, 0, v33
  v_perm_b32 v23, v33, v32, s31
  v_lshlrev_b32 v32, 16, v24
  v_and_b32 v33, s30, v24
  v_fma_f32 v32, v32, 0, v32
  v_fma_f32 v33, v33, 0, v33
  v_perm_b32 v24, v33, v32, s31
  v_lshlrev_b32 v32, 16, v25
  v_and_b32 v33, s30, v25
  v_fma_f32 v32, v32, 0, v32
  v_fma_f32 v33, v33, 0, v33
  v_perm_b32 v25, v33, v32, s31
  v_lshlrev_b32 v32, 16, v26
  v_and_b32 v33, s30, v26
  v_fma_f32 v32, v32, 0, v32
  v_fma_f32 v33, v33, 0, v33
  v_perm_b32 v26, v33, v32, s31
  v_lshlrev_b32 v32, 16, v27
  v_and_b32 v33, s30, v27
  v_fma_f32 v32, v32, 0, v32
  v_fma_f32 v33, v33, 0, v33
  v_perm_b32 v27, v33, v32, s31
  s_waitcnt lgkmcnt(0)
  v_sub_u32 v35, v35, v34
  s_barrier
  v_cmp_ne_u32 vcc, 0, v35
  s_and_b32 vcc_hi, vcc_hi, s24
  s_mov_b64 exec, vcc
  global_store_dwordx4 v5, v[16:19], s[14:15] offset:0 sc1
  s_mov_b64 exec, -1
  v_cmp_ne_u32 vcc, 1, v35
  s_and_b32 vcc_hi, vcc_hi, s25
  s_mov_b64 exec, vcc
  global_store_dwordx4 v5, v[20:23], s[14:15] offset:1152 sc1
  s_mov_b64 exec, -1
  v_cmp_ne_u32 vcc, 2, v35
  s_and_b32 vcc_hi, vcc_hi, s25
  s_mov_b64 exec, vcc
  global_store_dwordx4 v5, v[24:27], s[14:15] offset:2304 sc1
  s_endpgm
L_w9:
  s_cmp_ge_u32 s2, 256
  s_cbranch_scc1 L_end
  v_mov_b32 v20, 0xa0000
  s_setprio 3
  s_mov_b32 s40, 1664525
  s_waitcnt lgkmcnt(0)
  global_load_dword v20, v20, s[18:19] sc1
  s_mov_b32 s22, 0x80000
  v_lshl_add_u32 v21, v0, 6, s22
  v_min_u32 v22, 47, v0
  v_add_u32 v22, 64, v22
  v_lshl_add_u32 v22, v22, 6, s22
  v_mov_b32 v9, 4352
  s_mov_b32 s57, 262144
  s_cmp_ge_u32 s2, 112
  s_cbranch_scc1 L_fpoll
  s_lshr_b32 s33, s2, 3
  s_mul_i32 s20, s33, 4668
  s_lshr_b32 s20, s20, 8
  s_lshl_b32 s23, s21, 8
  s_add_u32 s20, s20, s23
  s_mul_i32 s22, s21, 14
  s_add_u32 s22, s22, s33
  s_lshl_b32 s22, s22, 6
  s_add_u32 s22, s22, 0x80000
  v_mov_b32 v6, s22
  global_load_dword v30, v6, s[18:19] sc1
  v_and_b32 v42, 31, v0
  v_mul_u32_u24 v43, 48, v42
  v_cmp_gt_u32 s[46:47], 19, v42
  s_sub_u32 s22, 2047, s20
  v_sub_u32 v42, s22, v42
  v_mov_b32 v34, 0
  s_brev_b32 s41, 1
  s_waitcnt vmcnt(1)
  v_mul_lo_u32 v20, v20, s40
  v_add_u32 v35, 1013904223, v20
  s_mov_b64 exec, s[46:47]
  s_barrier
  ds_read_b128 v[36:39], v43
  ds_read_b128 v[48:51], v43 offset:16
  ds_read_b32 v52, v43 offset:32
  s_waitcnt lgkmcnt(2)
  v_pk_add_f32 v[36:37], v[36:37], v[38:39]
  s_waitcnt lgkmcnt(1)
  v_pk_add_f32 v[48:49], v[48:49], v[50:51]
  v_pk_add_f32 v[36:37], v[36:37], v[48:49]
  v_add_f32 v36, v36, v37
  s_waitcnt lgkmcnt(0)
  v_add_f32 v36, v36, v52
  v_cmp_o_f32 vcc, v36, v36
  v_cvt_pk_bf16_f32 v36, 0, v36
  v_ashrrev_i32 v37, 31, v36
  v_lshl_or_b32 v37, v37, 16, s41
  v_xor_b32 v36, v36, v37
  v_cndmask_b32 v36, 0, v36, vcc
  v_or_b32 v34, v36, v42
  s_mov_b64 exec, -1
  s_nop 0
  v_max_u32_dpp v34, v34, v34 quad_perm:[1,0,3,2] row_mask:0xf bank_mask:0xf
  s_nop 1
  v_max_u32_dpp v34, v34, v34 quad_perm:[2,3,0,1] row_mask:0xf bank_mask:0xf
  s_nop 1
  v_max_u32_dpp v34, v34, v34 row_half_mirror row_mask:0xf bank_mask:0xf
  s_nop 1
  v_max_u32_dpp v34, v34, v34 row_mirror row_mask:0xf bank_mask:0xf
  s_nop 1
  v_max_u32_dpp v34, v34, v34 row_bcast:15 row_mask:0xa bank_mask:0xf
  s_mov_b32 exec_lo, s41
  s_mov_b32 exec_hi, 0
  global_store_dwordx2 v6, v[34:35], s[18:19] sc1
  s_barrier
  s_mov_b64 exec, -1
  s_barrier
L_rp_loop:
  global_load_dwordx2 v[24:25], v21, s[18:19] sc1
  global_load_dwordx2 v[26:27], v22, s[18:19] sc1
  s_sub_u32 s57, s57, 1
  s_cselect_b64 s[36:37], -1, 0
  s_waitcnt vmcnt(0)
  v_max_u32 v24, v24, v26
  v_cmp_eq_u32 vcc, v25, v35
  v_cmp_eq_u32 s[42:43], v27, v35
  v_max_u32_dpp v24, v24, v24 quad_perm:[1,0,3,2] row_mask:0xf bank_mask:0xf
  s_and_b64 vcc, vcc, s[42:43]
  s_or_b64 vcc, vcc, s[36:37]
  v_max_u32_dpp v24, v24, v24 quad_perm:[2,3,0,1] row_mask:0xf bank_mask:0xf
  s_cmp_eq_u64 vcc, -1
  s_cbranch_scc0 L_rp_loop
  v_max_u32_dpp v24, v24, v24 row_half_mirror row_mask:0xf bank_mask:0xf
  s_nop 1
  v_max_u32_dpp v24, v24, v24 row_mirror row_mask:0xf bank_mask:0xf
  s_nop 1
  v_max_u32_dpp v24, v24, v24 row_bcast:15 row_mask:0xa bank_mask:0xf
  s_nop 1
  v_max_u32_dpp v24, v24, v24 row_bcast:31 row_mask:0xc bank_mask:0xf
  s_nop 0
  v_readlane_b32 s26, v24, 63
  s_andn2_b32 s25, 0x7ff, s26
  s_sub_u32 s25, s25, s20
  v_mov_b32 v8, s25
  ds_write_b32 v9, v8
  s_waitcnt lgkmcnt(0)
  s_barrier
  s_endpgm
L_fpoll:
  v_lshlrev_b32 v7, 4, v0
  s_mov_b32 m0, 0
  s_sub_u32 s50, s2, 112
  s_lshr_b32 s50, s50, 3
  s_mul_i32 s51, s21, 6
  s_cmp_ge_u32 s50, 6
  s_cselect_b32 s51, 42, s51
  s_add_u32 s51, s51, s50
  s_cmp_eq_u32 s21, 7
  s_cselect_b32 s52, 12, 6
  s_cmp_lt_u32 s50, s52
  s_cselect_b32 s51, s51, 63
  s_mul_i32 s28, s51, 10923
  s_lshr_b32 s28, s28, 16
  s_mul_i32 s29, s28, 6
  s_sub_u32 s29, s51, s29
  s_lshr_b32 s30, s29, 1
  s_and_b32 s29, s29, 1
  s_lshl_b32 s27, s28, 7
  s_lshl_b32 s29, s29, 6
  s_add_u32 s27, s27, s29
  s_mul_i32 s29, s30, 6
  s_add_u32 s27, s27, s29
  s_movk_i32 s48, 0x7777
  s_cmp_eq_u32 s30, 2
  s_cselect_b32 s48, 0x3333, s48
  s_mov_b32 s49, 0
  v_and_b32 v49, 15, v0
  v_lshrrev_b32 v50, 2, v49
  v_lshlrev_b32 v50, 4, v50
  v_and_b32 v51, 3, v49
  v_lshl_add_u32 v50, v51, 1, v50
  v_add_u32 v50, s27, v50
  v_mul_u32_u24 v54, 48, v49
  v_add_u32 v54, 5120, v54
  s_barrier
  s_waitcnt vmcnt(0)
  v_mul_lo_u32 v20, v20, s40
  v_add_u32 v20, 1013904223, v20
  ds_write_b32 v9, v20
  s_waitcnt lgkmcnt(0)
  s_barrier
L_fp_loop:
  global_load_dwordx2 v[24:25], v21, s[18:19] sc1
  global_load_dwordx2 v[26:27], v22, s[18:19] sc1
  s_sub_u32 s57, s57, 1
  s_cselect_b64 s[36:37], -1, 0
  s_waitcnt vmcnt(0)
  v_max_u32 v24, v24, v26
  v_cmp_eq_u32 vcc, v25, v20
  v_cmp_eq_u32 s[42:43], v27, v20
  v_max_u32_dpp v24, v24, v24 quad_perm:[1,0,3,2] row_mask:0xf bank_mask:0xf
  s_and_b64 vcc, vcc, s[42:43]
  s_or_b64 vcc, vcc, s[36:37]
  v_max_u32_dpp v24, v24, v24 quad_perm:[2,3,0,1] row_mask:0xf bank_mask:0xf
  s_cmp_eq_u64 vcc, -1
  s_cbranch_scc0 L_fp_loop
  v_max_u32_dpp v24, v24, v24 row_half_mirror row_mask:0xf bank_mask:0xf
  s_nop 1
  v_max_u32_dpp v24, v24, v24 row_mirror row_mask:0xf bank_mask:0xf
  s_nop 1
  v_max_u32_dpp v24, v24, v24 row_bcast:15 row_mask:0xa bank_mask:0xf
  s_nop 1
  v_max_u32_dpp v24, v24, v24 row_bcast:31 row_mask:0xc bank_mask:0xf
  s_nop 0
  v_readlane_b32 s26, v24, 63
  s_andn2_b32 s25, 0x7ff, s26
  s_mul_i32 s25, s25, 1152
  v_add_u32 v5, s25, v7
  global_load_lds_dwordx4 v5, s[4:5]
  s_mov_b64 exec, 0xff
  global_load_lds_dwordx4 v5, s[4:5] offset:1024
  s_barrier
  s_cmp_lg_u32 s51, 63
  s_waitcnt vmcnt(0)
  s_barrier
  s_cbranch_scc1 L_fin
  s_endpgm
L_fin:
  s_setprio 0
  s_barrier
  s_mov_b64 exec, s[48:49]
  ds_read_u16 v51, v50
  s_and_b32 s27, s26, 0xffff0000
  s_ashr_i32 s28, s27, 31
  s_not_b32 s28, s28
  s_or_b32 s28, s28, 0x80000000
  s_xor_b32 s27, s27, s28
  s_and_b32 s27, s27, 0xffff0000
  s_barrier
  v_add_u32 v50, s25, v50
  v_mov_b32 v52, 0xbfb8aa3b
  v_mul_f32 v52, s27, v52
  v_exp_f32 v52, v52
  s_nop 0
  v_add_f32 v52, 1.0, v52
  v_rcp_f32 v52, v52
  s_nop 0
  v_cvt_pk_bf16_f32 v52, 0, v52
  s_waitcnt lgkmcnt(0)
  v_lshlrev_b32 v51, 16, v51
  v_fma_f32 v51, v51, 0, v51
  s_barrier
  ds_read_b128 v[32:35], v54
  ds_read_b128 v[36:39], v54 offset:16
  ds_read_b32 v48, v54 offset:32
  s_waitcnt lgkmcnt(2)
  v_pk_add_f32 v[32:33], v[32:33], v[34:35]
  s_waitcnt lgkmcnt(1)
  v_pk_add_f32 v[36:37], v[36:37], v[38:39]
  v_pk_add_f32 v[32:33], v[32:33], v[36:37]
  v_add_f32 v32, v32, v33
  s_waitcnt lgkmcnt(0)
  v_add_f32 v32, v32, v48
  v_cvt_pk_bf16_f32 v32, 0, v32
  v_mul_f32 v32, v32, v52
  v_cvt_pk_bf16_f32 v32, 0, v32
  v_add_f32 v32, v51, v32
  v_cvt_pk_bf16_f32 v32, v32, v32
  global_store_short v50, v32, s[14:15]
L_end:
  s_endpgm
L_codeend:
.section .rodata,"a"
.p2align 6
.amdhsa_kernel standalone__moe_arch_mod__prompt_kernel
  .amdhsa_next_free_vgpr 156
  .amdhsa_next_free_sgpr 80
  .amdhsa_accum_offset 156
  .amdhsa_group_segment_fixed_size 0
  .amdhsa_kernarg_size 64
  .amdhsa_user_sgpr_count 2
  .amdhsa_user_sgpr_kernarg_segment_ptr 1
  .amdhsa_system_sgpr_workgroup_id_x 1
  .amdhsa_float_denorm_mode_32 3
.end_amdhsa_kernel
```
